```python
import torch

def _softmax(x, axis=-1):
    return torch.softmax(x, dim=axis)

def _gelu(x):
    return torch.nn.functional.gelu(x, approximate='tanh')

def _silu(x):
    return torch.nn.functional.silu(x)

def _sigmoid(x):
    return torch.sigmoid(x)

def _layernorm(x, axis=-1, eps=1e-05):
    m = x.mean(dim=axis, keepdim=True)
    v = x.var(dim=axis, keepdim=True, unbiased=False)
    return (x - m) / torch.sqrt(v + eps)

def _scatter_add(tgt, idx, src, axis=0):
    return tgt.clone().index_add_(axis, idx, src)

def _segment_sum(src, seg, n):
    out = torch.zeros((n,) + src.shape[1:], dtype=src.dtype)
    return out.index_add_(0, seg, src)

def _pad(x, pw):
    flat = tuple((v for pair in reversed(pw) for v in pair))
    return torch.nn.functional.pad(x, flat)
kernel_name = 'standalone__kv_cache_quant_pre_rope_vs_post_rope__decode'

def setup_inputs():

    _w = lambda a: (lambda t: t.to(torch.bfloat16) if t.is_floating_point() else t)(torch.as_tensor(a))
    B, Sq, Skv = (2, 1, 4096)
    H, Dh0 = (32, 192)
    G = 128 if 128 > 0 else Dh0
    G = max(2, G // 2 * 2)
    Dh = max(G, Dh0 // G * G)
    Skv = max(Skv, Sq)
    ng = Dh // G
    bits = 8 if 8 > 1 else 4
    bits = max(2, min(8, bits))
    qmax = (1 << bits) - 1
    half = Dh // 2
    inv = 1.0 / 10000.0 ** (torch.arange(half) / max(1, half))
    ang_k = torch.arange(Skv)[:, None] * inv[None, :]
    ang_q = torch.arange(Skv - Sq, Skv)[:, None] * inv[None, :]
    kc = torch.cat([torch.cos(ang_k), torch.cos(ang_k)], dim=-1)
    ks = torch.cat([torch.sin(ang_k), torch.sin(ang_k)], dim=-1)
    qc = torch.cat([torch.cos(ang_q), torch.cos(ang_q)], dim=-1)
    qs = torch.cat([torch.sin(ang_q), torch.sin(ang_q)], dim=-1)
    qk_i = torch.randint(0, qmax + 1, (B, H, Skv, Dh)).to(torch.int32)
    qv_i = torch.randint(0, qmax + 1, (B, H, Skv, Dh)).to(torch.int32)
    ksc = torch.abs((lambda *s: torch.randn(*s, dtype=torch.bfloat16) * 0.05)(B, H, Skv, ng)) * 0.1 + 0.01
    kzp = torch.full((B, H, Skv, ng), qmax / 2.0)
    vsc = torch.abs((lambda *s: torch.randn(*s, dtype=torch.bfloat16) * 0.05)(B, H, Skv, ng)) * 0.1 + 0.01
    vzp = torch.full((B, H, Skv, ng), qmax / 2.0)
    return {'q': _w((lambda *s: torch.randn(*s, dtype=torch.bfloat16) * 0.8)(B, H, Sq, Dh) * 0.5), 'qk': _w(qk_i), 'k_scales': _w(ksc), 'k_zeros': _w(kzp), 'qv': _w(qv_i), 'v_scales': _w(vsc), 'v_zeros': _w(vzp), 'q_cos': _w(qc), 'q_sin': _w(qs), 'k_cos': _w(kc), 'k_sin': _w(ks)}

def reference(q, qk, k_scales, k_zeros, qv, v_scales, v_zeros, q_cos, q_sin, k_cos, k_sin):
    B, H, Sq, Dh = q.shape
    ng = k_scales.shape[-1]
    G = Dh // ng
    half = Dh // 2
    ks = (lambda x, n, axis: torch.repeat_interleave(x, n, dim=axis))(k_scales, G, axis=-1)
    kz = (lambda x, n, axis: torch.repeat_interleave(x, n, dim=axis))(k_zeros, G, axis=-1)
    k = ((lambda x, dt: x.to(dt))(qk, q.dtype) - kz) * ks
    vs = (lambda x, n, axis: torch.repeat_interleave(x, n, dim=axis))(v_scales, G, axis=-1)
    vz = (lambda x, n, axis: torch.repeat_interleave(x, n, dim=axis))(v_zeros, G, axis=-1)
    v = ((lambda x, dt: x.to(dt))(qv, q.dtype) - vz) * vs
    k1 = k[..., :half].clone()
    k2 = k[..., half:].clone()
    krh = torch.concatenate([-k2, k1], axis=-1)
    kr = k * k_cos[None, None, :, :] + krh * k_sin[None, None, :, :]
    q1 = q[..., :half].clone()
    q2 = q[..., half:].clone()
    qrh = torch.concatenate([-q2, q1], axis=-1)
    qr = q * q_cos[None, None, :, :] + qrh * q_sin[None, None, :, :]
    logits = torch.einsum('bhqd,bhkd->bhqk', qr, kr) * float(Dh) ** (-0.5)
    attn = _softmax(logits, axis=-1)
    out = torch.einsum('bhqk,bhkd->bhqd', attn, v)
    return out
```

```asm
; @launch grid=(256,1,1) block=(512,1,1) lds=58368
.amdgcn_target "amdgcn-amd-amdhsa--gfx950"
.text
.globl standalone__kv_cache_quant_pre_rope_vs_post_rope__decode_kernel
.p2align 8
.type standalone__kv_cache_quant_pre_rope_vs_post_rope__decode_kernel,@function
standalone__kv_cache_quant_pre_rope_vs_post_rope__decode_kernel:
    s_cmp_ge_u32 s2, 256
    s_cbranch_scc1 L_end
    s_load_dwordx16 s[16:31], s[0:1], 0
    s_load_dwordx8 s[32:39], s[0:1], 64
    s_load_dwordx4 s[40:43], s[0:1], 96
    v_lshrrev_b32 v228, 6, v0
    v_and_b32 v1, 63, v0
    s_and_b32 s53, s2, 15
    v_readfirstlane_b32 s54, v228
    s_lshr_b32 s66, s2, 4
    s_mov_b32 s56, 0
    s_mov_b32 s57, 32768
    s_mov_b32 s58, 65536
    s_mov_b32 s59, 98304
    s_mov_b32 s64, 0x05040100
    s_mov_b32 s65, 0x07060302
    v_lshrrev_b32 v229, 3, v1
    v_and_b32 v230, 7, v1
    v_lshlrev_b32 v2, 9, v229
    v_lshl_add_u32 v2, v230, 4, v2
    v_mov_b32 v3, v2
    s_mul_i32 s67, s54, 5120
    s_add_u32 s67, s67, 17408
    v_lshlrev_b32 v4, 3, v230
    v_add_u32 v4, s67, v4
    v_lshlrev_b32 v5, 4, v229
    v_add_u32 v5, s67, v5
    s_lshl_b32 s3, s54, 9
    v_lshrrev_b32 v6, 4, v1
    v_lshlrev_b32 v6, 7, v6
    v_lshl_add_u32 v6, v230, 4, v6
    v_add_u32 v6, s3, v6
    v_lshlrev_b32 v231, 8, v229
    v_lshl_add_u32 v231, v230, 3, v231
    v_add_u32 v234, 16384, v231
    v_add_u32 v235, 32768, v231
    v_add_u32 v236, 49152, v231
    v_lshlrev_b32 v232, 2, v1
    v_xor_b32 v233, 128, v232
    v_lshrrev_b32 v238, 2, v1
    v_and_b32 v238, 3, v238
    v_and_b32 v239, 3, v1
    v_lshlrev_b32 v237, 17, v238
    v_mul_u32_u24 v239, 128, v239
    v_add_u32 v237, v237, v239
    s_waitcnt lgkmcnt(0)
    s_lshl_b32 s3, s66, 21
    s_mul_i32 s4, s53, 131072
    s_add_u32 s3, s3, s4
    s_mul_i32 s4, s54, 4096
    s_add_u32 s3, s3, s4
    s_add_u32 s44, s18, s3
    s_addc_u32 s45, s19, 0
    s_and_b32 s45, s45, 0xffff
    s_mov_b32 s46, 0x6019000
    s_mov_b32 s47, 0x00020000
    s_add_u32 s48, s24, s3
    s_addc_u32 s49, s25, 0
    s_and_b32 s49, s49, 0xffff
    s_mov_b32 s50, 0x6019000
    s_mov_b32 s51, 0x00020000
    s_lshl_b32 s3, s66, 8
    s_add_u32 s16, s16, s3
    s_addc_u32 s17, s17, 0
    global_load_dword v124, v232, s[30:31]
    global_load_dword v125, v232, s[32:33]
    global_load_dword v116, v232, s[16:17]
    global_load_dword v117, v233, s[16:17]
    s_add_u32 s16, s16, 4096
    s_addc_u32 s17, s17, 0
    global_load_dword v118, v232, s[16:17]
    global_load_dword v119, v233, s[16:17]
    s_add_u32 s16, s16, 4096
    s_addc_u32 s17, s17, 0
    global_load_dword v120, v232, s[16:17]
    global_load_dword v121, v233, s[16:17]
    s_add_u32 s16, s16, 4096
    s_addc_u32 s17, s17, 0
    global_load_dword v122, v232, s[16:17]
    global_load_dword v123, v233, s[16:17]
    s_lshl_b32 s3, s66, 13
    s_mul_i32 s4, s53, 512
    s_add_u32 s3, s3, s4
    s_mul_i32 s4, s54, 16
    s_add_u32 s3, s3, s4
    s_add_u32 s20, s20, s3
    s_addc_u32 s21, s21, 0
    global_load_dwordx4 v[100:103], v237, s[20:21]
    s_add_u32 s22, s22, s3
    s_addc_u32 s23, s23, 0
    global_load_dwordx4 v[104:107], v237, s[22:23]
    s_add_u32 s26, s26, s3
    s_addc_u32 s27, s27, 0
    global_load_dwordx4 v[108:111], v237, s[26:27]
    s_add_u32 s28, s28, s3
    s_addc_u32 s29, s29, 0
    global_load_dwordx4 v[112:115], v237, s[28:29]
    s_mul_i32 s3, s53, 65536
    s_mul_i32 s4, s54, 2048
    s_add_u32 s3, s3, s4
    s_add_u32 s34, s34, s3
    s_addc_u32 s35, s35, 0
    s_add_u32 s36, s36, s3
    s_addc_u32 s37, s37, 0
    global_load_dwordx2 v[36:37], v231, s[34:35] offset:0
    global_load_dwordx2 v[38:39], v231, s[36:37] offset:128
    global_load_dwordx2 v[40:41], v231, s[34:35] offset:64
    global_load_dwordx2 v[42:43], v231, s[36:37] offset:192
    global_load_dwordx2 v[44:45], v231, s[34:35] offset:128
    global_load_dwordx2 v[46:47], v231, s[36:37] offset:0
    global_load_dwordx2 v[48:49], v231, s[34:35] offset:192
    global_load_dwordx2 v[50:51], v231, s[36:37] offset:64
    global_load_dwordx2 v[52:53], v234, s[34:35] offset:0
    global_load_dwordx2 v[54:55], v234, s[36:37] offset:128
    global_load_dwordx2 v[56:57], v234, s[34:35] offset:64
    global_load_dwordx2 v[58:59], v234, s[36:37] offset:192
    global_load_dwordx2 v[60:61], v234, s[34:35] offset:128
    global_load_dwordx2 v[62:63], v234, s[36:37] offset:0
    global_load_dwordx2 v[64:65], v234, s[34:35] offset:192
    global_load_dwordx2 v[66:67], v234, s[36:37] offset:64
    global_load_dwordx2 v[68:69], v235, s[34:35] offset:0
    global_load_dwordx2 v[70:71], v235, s[36:37] offset:128
    global_load_dwordx2 v[72:73], v235, s[34:35] offset:64
    global_load_dwordx2 v[74:75], v235, s[36:37] offset:192
    global_load_dwordx2 v[76:77], v235, s[34:35] offset:128
    global_load_dwordx2 v[78:79], v235, s[36:37] offset:0
    global_load_dwordx2 v[80:81], v235, s[34:35] offset:192
    global_load_dwordx2 v[82:83], v235, s[36:37] offset:64
    global_load_dwordx2 v[84:85], v236, s[34:35] offset:0
    global_load_dwordx2 v[86:87], v236, s[36:37] offset:128
    global_load_dwordx2 v[88:89], v236, s[34:35] offset:64
    global_load_dwordx2 v[90:91], v236, s[36:37] offset:192
    global_load_dwordx2 v[92:93], v236, s[34:35] offset:128
    global_load_dwordx2 v[94:95], v236, s[36:37] offset:0
    global_load_dwordx2 v[96:97], v236, s[34:35] offset:192
    global_load_dwordx2 v[98:99], v236, s[36:37] offset:64
    buffer_load_dwordx4 v[164:167], v2, s[44:47], s56 offen offset:0 nt
    buffer_load_dwordx4 v[168:171], v2, s[44:47], s56 offen offset:128 nt
    buffer_load_dwordx4 v[172:175], v2, s[44:47], s56 offen offset:256 nt
    buffer_load_dwordx4 v[176:179], v2, s[44:47], s56 offen offset:384 nt
    buffer_load_dwordx4 v[180:183], v2, s[44:47], s57 offen offset:0 nt
    buffer_load_dwordx4 v[184:187], v2, s[44:47], s57 offen offset:128 nt
    buffer_load_dwordx4 v[188:191], v2, s[44:47], s57 offen offset:256 nt
    buffer_load_dwordx4 v[192:195], v2, s[44:47], s57 offen offset:384 nt
    buffer_load_dwordx4 v[196:199], v2, s[44:47], s58 offen offset:0 nt
    buffer_load_dwordx4 v[200:203], v2, s[44:47], s58 offen offset:128 nt
    buffer_load_dwordx4 v[204:207], v2, s[44:47], s58 offen offset:256 nt
    buffer_load_dwordx4 v[208:211], v2, s[44:47], s58 offen offset:384 nt
    buffer_load_dwordx4 v[212:215], v2, s[44:47], s59 offen offset:0 nt
    buffer_load_dwordx4 v[216:219], v2, s[44:47], s59 offen offset:128 nt
    buffer_load_dwordx4 v[220:223], v2, s[44:47], s59 offen offset:256 nt
    buffer_load_dwordx4 v[224:227], v2, s[44:47], s59 offen offset:384 nt
    v_add_u32 v2, 0x2000000, v2
    s_min_u32 s5, s54, 3
    s_mul_i32 s3, s5, 16
    s_add_u32 s72, s3, s66
    s_mul_i32 s3, s72, 8192
    s_add_u32 s8, s42, s3
    s_addc_u32 s9, s43, 0
    s_lshl_b32 s4, s53, 9
    s_add_u32 s10, s8, s4
    s_addc_u32 s11, s9, 0
    s_mul_i32 s3, s72, 256
    s_add_u32 s3, s3, 1048576
    s_add_u32 s12, s42, s3
    s_addc_u32 s13, s43, 0
    s_lshl_b32 s4, s53, 3
    s_add_u32 s14, s12, s4
    s_addc_u32 s15, s13, 0
    s_waitcnt vmcnt(52)
    v_cmp_gt_u32 vcc, 32, v1
    v_mov_b32 v238, 0x80008000
    v_mov_b32 v239, 0
    v_add_u32 v228, s67, v232
    v_cndmask_b32 v238, v239, v238, vcc
    v_lshlrev_b32 v26, 16, v124
    v_and_b32 v27, 0xffff0000, v124
    v_lshlrev_b32 v28, 16, v125
    v_and_b32 v29, 0xffff0000, v125
    v_xor_b32 v117, v117, v238
    v_lshlrev_b32 v22, 16, v116
    v_and_b32 v23, 0xffff0000, v116
    v_lshlrev_b32 v24, 16, v117
    v_and_b32 v25, 0xffff0000, v117
    v_mul_f32 v22, v22, v26
    v_mul_f32 v23, v23, v27
    v_mul_f32 v24, v24, v28
    v_mul_f32 v25, v25, v29
    v_cvt_pk_bf16_f32 v30, v22, v23
    v_cvt_pk_bf16_f32 v31, v24, v25
    v_lshlrev_b32 v22, 16, v30
    v_and_b32 v23, 0xffff0000, v30
    v_lshlrev_b32 v24, 16, v31
    v_and_b32 v25, 0xffff0000, v31
    v_add_f32 v22, v22, v24
    v_add_f32 v23, v23, v25
    v_cvt_pk_bf16_f32 v116, v22, v23
    v_xor_b32 v117, 0x80008000, v116
    ds_write_b32 v228, v116 offset:0
    ds_write_b32 v228, v117 offset:256
    v_xor_b32 v119, v119, v238
    v_lshlrev_b32 v22, 16, v118
    v_and_b32 v23, 0xffff0000, v118
    v_lshlrev_b32 v24, 16, v119
    v_and_b32 v25, 0xffff0000, v119
    v_mul_f32 v22, v22, v26
    v_mul_f32 v23, v23, v27
    v_mul_f32 v24, v24, v28
    v_mul_f32 v25, v25, v29
    v_cvt_pk_bf16_f32 v30, v22, v23
    v_cvt_pk_bf16_f32 v31, v24, v25
    v_lshlrev_b32 v22, 16, v30
    v_and_b32 v23, 0xffff0000, v30
    v_lshlrev_b32 v24, 16, v31
    v_and_b32 v25, 0xffff0000, v31
    v_add_f32 v22, v22, v24
    v_add_f32 v23, v23, v25
    v_cvt_pk_bf16_f32 v118, v22, v23
    v_xor_b32 v119, 0x80008000, v118
    ds_write_b32 v228, v118 offset:512
    ds_write_b32 v228, v119 offset:768
    v_xor_b32 v121, v121, v238
    v_lshlrev_b32 v22, 16, v120
    v_and_b32 v23, 0xffff0000, v120
    v_lshlrev_b32 v24, 16, v121
    v_and_b32 v25, 0xffff0000, v121
    v_mul_f32 v22, v22, v26
    v_mul_f32 v23, v23, v27
    v_mul_f32 v24, v24, v28
    v_mul_f32 v25, v25, v29
    v_cvt_pk_bf16_f32 v30, v22, v23
    v_cvt_pk_bf16_f32 v31, v24, v25
    v_lshlrev_b32 v22, 16, v30
    v_and_b32 v23, 0xffff0000, v30
    v_lshlrev_b32 v24, 16, v31
    v_and_b32 v25, 0xffff0000, v31
    v_add_f32 v22, v22, v24
    v_add_f32 v23, v23, v25
    v_cvt_pk_bf16_f32 v120, v22, v23
    v_xor_b32 v121, 0x80008000, v120
    ds_write_b32 v228, v120 offset:1024
    ds_write_b32 v228, v121 offset:1280
    v_xor_b32 v123, v123, v238
    v_lshlrev_b32 v22, 16, v122
    v_and_b32 v23, 0xffff0000, v122
    v_lshlrev_b32 v24, 16, v123
    v_and_b32 v25, 0xffff0000, v123
    v_mul_f32 v22, v22, v26
    v_mul_f32 v23, v23, v27
    v_mul_f32 v24, v24, v28
    v_mul_f32 v25, v25, v29
    v_cvt_pk_bf16_f32 v30, v22, v23
    v_cvt_pk_bf16_f32 v31, v24, v25
    v_lshlrev_b32 v22, 16, v30
    v_and_b32 v23, 0xffff0000, v30
    v_lshlrev_b32 v24, 16, v31
    v_and_b32 v25, 0xffff0000, v31
    v_add_f32 v22, v22, v24
    v_add_f32 v23, v23, v25
    v_cvt_pk_bf16_f32 v122, v22, v23
    v_xor_b32 v123, 0x80008000, v122
    ds_write_b32 v228, v122 offset:1536
    ds_write_b32 v228, v123 offset:1792
    s_waitcnt vmcnt(48)
    s_mov_b32 s3, 0x3e0293ee
    v_lshlrev_b32 v228, 7, v1
    v_add_u32 v228, s67, v228
    s_mov_b64 exec, 0xffff
    v_lshlrev_b32 v22, 16, v100
    v_and_b32 v26, 0xffff0000, v100
    v_lshlrev_b32 v23, 16, v104
    v_and_b32 v27, 0xffff0000, v104
    v_lshlrev_b32 v24, 16, v108
    v_and_b32 v28, 0xffff0000, v108
    v_lshlrev_b32 v25, 16, v112
    v_and_b32 v29, 0xffff0000, v112
    v_mul_f32 v22, s3, v22
    v_mul_f32 v26, s3, v26
    ds_write_b128 v228, v[22:25] offset:2560
    ds_write_b128 v228, v[26:29] offset:2576
    v_lshlrev_b32 v22, 16, v101
    v_and_b32 v26, 0xffff0000, v101
    v_lshlrev_b32 v23, 16, v105
    v_and_b32 v27, 0xffff0000, v105
    v_lshlrev_b32 v24, 16, v109
    v_and_b32 v28, 0xffff0000, v109
    v_lshlrev_b32 v25, 16, v113
    v_and_b32 v29, 0xffff0000, v113
    v_mul_f32 v22, s3, v22
    v_mul_f32 v26, s3, v26
    ds_write_b128 v228, v[22:25] offset:2592
    ds_write_b128 v228, v[26:29] offset:2608
    v_lshlrev_b32 v22, 16, v102
    v_and_b32 v26, 0xffff0000, v102
    v_lshlrev_b32 v23, 16, v106
    v_and_b32 v27, 0xffff0000, v106
    v_lshlrev_b32 v24, 16, v110
    v_and_b32 v28, 0xffff0000, v110
    v_lshlrev_b32 v25, 16, v114
    v_and_b32 v29, 0xffff0000, v114
    v_mul_f32 v22, s3, v22
    v_mul_f32 v26, s3, v26
    ds_write_b128 v228, v[22:25] offset:2624
    ds_write_b128 v228, v[26:29] offset:2640
    v_lshlrev_b32 v22, 16, v103
    v_and_b32 v26, 0xffff0000, v103
    v_lshlrev_b32 v23, 16, v107
    v_and_b32 v27, 0xffff0000, v107
    v_lshlrev_b32 v24, 16, v111
    v_and_b32 v28, 0xffff0000, v111
    v_lshlrev_b32 v25, 16, v115
    v_and_b32 v29, 0xffff0000, v115
    v_mul_f32 v22, s3, v22
    v_mul_f32 v26, s3, v26
    ds_write_b128 v228, v[22:25] offset:2656
    ds_write_b128 v228, v[26:29] offset:2672
    s_mov_b64 exec, -1
    s_waitcnt lgkmcnt(0)
    ds_read_b64 v[22:23], v4 offset:0
    ds_read_b64 v[24:25], v4 offset:64
    ds_read_b64 v[26:27], v4 offset:128
    ds_read_b64 v[28:29], v4 offset:192
    ds_read_b64 v[30:31], v4 offset:256
    ds_read_b64 v[32:33], v4 offset:320
    s_waitcnt vmcnt(40)
    v_perm_b32 v100, v38, v36, s64
    v_perm_b32 v101, v38, v36, s65
    v_perm_b32 v102, v39, v37, s64
    v_perm_b32 v103, v39, v37, s65
    v_perm_b32 v104, v42, v40, s64
    v_perm_b32 v105, v42, v40, s65
    v_perm_b32 v106, v43, v41, s64
    v_perm_b32 v107, v43, v41, s65
    v_perm_b32 v108, v46, v44, s64
    v_perm_b32 v109, v46, v44, s65
    v_perm_b32 v110, v47, v45, s64
    v_perm_b32 v111, v47, v45, s65
    v_perm_b32 v112, v50, v48, s64
    v_perm_b32 v113, v50, v48, s65
    v_perm_b32 v114, v51, v49, s64
    v_perm_b32 v115, v51, v49, s65
    s_waitcnt vmcnt(32)
    v_perm_b32 v116, v54, v52, s64
    v_perm_b32 v117, v54, v52, s65
    v_perm_b32 v118, v55, v53, s64
    v_perm_b32 v119, v55, v53, s65
    v_perm_b32 v120, v58, v56, s64
    v_perm_b32 v121, v58, v56, s65
    v_perm_b32 v122, v59, v57, s64
    v_perm_b32 v123, v59, v57, s65
    v_perm_b32 v124, v62, v60, s64
    v_perm_b32 v125, v62, v60, s65
    v_perm_b32 v126, v63, v61, s64
    v_perm_b32 v127, v63, v61, s65
    v_perm_b32 v128, v66, v64, s64
    v_perm_b32 v129, v66, v64, s65
    v_perm_b32 v130, v67, v65, s64
    v_perm_b32 v131, v67, v65, s65
    s_waitcnt vmcnt(24)
    v_perm_b32 v132, v70, v68, s64
    v_perm_b32 v133, v70, v68, s65
    v_perm_b32 v134, v71, v69, s64
    v_perm_b32 v135, v71, v69, s65
    v_perm_b32 v136, v74, v72, s64
    v_perm_b32 v137, v74, v72, s65
    v_perm_b32 v138, v75, v73, s64
    v_perm_b32 v139, v75, v73, s65
    v_perm_b32 v140, v78, v76, s64
    v_perm_b32 v141, v78, v76, s65
    v_perm_b32 v142, v79, v77, s64
    v_perm_b32 v143, v79, v77, s65
    v_perm_b32 v144, v82, v80, s64
    v_perm_b32 v145, v82, v80, s65
    v_perm_b32 v146, v83, v81, s64
    v_perm_b32 v147, v83, v81, s65
    s_waitcnt vmcnt(16)
    v_perm_b32 v148, v86, v84, s64
    v_perm_b32 v149, v86, v84, s65
    v_perm_b32 v150, v87, v85, s64
    v_perm_b32 v151, v87, v85, s65
    v_perm_b32 v152, v90, v88, s64
    v_perm_b32 v153, v90, v88, s65
    v_perm_b32 v154, v91, v89, s64
    v_perm_b32 v155, v91, v89, s65
    v_perm_b32 v156, v94, v92, s64
    v_perm_b32 v157, v94, v92, s65
    v_perm_b32 v158, v95, v93, s64
    v_perm_b32 v159, v95, v93, s65
    v_perm_b32 v160, v98, v96, s64
    v_perm_b32 v161, v98, v96, s65
    v_perm_b32 v162, v99, v97, s64
    v_perm_b32 v163, v99, v97, s65
    ds_read_b128 v[84:87], v5 offset:2560
    ds_read_b128 v[88:91], v5 offset:2688
    ds_read_b128 v[92:95], v5 offset:2816
    ds_read_b128 v[96:99], v5 offset:2944
    s_mov_b32 s55, 0
L_loop:
    s_waitcnt lgkmcnt(0)
    v_perm_b32 v52, v26, v22, s64
    v_perm_b32 v53, v26, v22, s65
    v_perm_b32 v54, v27, v23, s64
    v_perm_b32 v55, v27, v23, s65
    v_perm_b32 v56, v28, v24, s64
    v_perm_b32 v57, v28, v24, s65
    v_perm_b32 v58, v29, v25, s64
    v_perm_b32 v59, v29, v25, s65
    v_perm_b32 v60, v30, v26, s64
    v_perm_b32 v61, v30, v26, s65
    v_perm_b32 v62, v31, v27, s64
    v_perm_b32 v63, v31, v27, s65
    v_perm_b32 v64, v32, v28, s64
    v_perm_b32 v65, v32, v28, s65
    v_perm_b32 v66, v33, v29, s64
    v_perm_b32 v67, v33, v29, s65
    v_add_u32 v4, 512, v4
    ds_read_b64 v[22:23], v4 offset:0
    ds_read_b64 v[24:25], v4 offset:64
    ds_read_b64 v[26:27], v4 offset:128
    ds_read_b64 v[28:29], v4 offset:192
    ds_read_b64 v[30:31], v4 offset:256
    ds_read_b64 v[32:33], v4 offset:320
    v_dot2_f32_bf16 v44, v52, v100, 0
    v_dot2_f32_bf16 v45, v53, v101, 0
    v_dot2_f32_bf16 v46, v54, v102, 0
    v_dot2_f32_bf16 v47, v55, v103, 0
    s_waitcnt vmcnt(15)
    v_cvt_f32_i32 v36, v164
    v_cvt_f32_i32 v37, v165
    v_cvt_f32_i32 v38, v166
    v_cvt_f32_i32 v39, v167
    buffer_load_dwordx4 v[164:167], v3, s[48:51], s56 offen offset:0 nt
    v_sub_f32 v36, v36, v85
    v_sub_f32 v37, v37, v85
    v_sub_f32 v38, v38, v85
    v_sub_f32 v39, v39, v85
    v_mul_f32 v8, v36, v44
    v_mul_f32 v9, v37, v45
    v_fmac_f32 v8, v38, v46
    v_fmac_f32 v9, v39, v47
    v_dot2_f32_bf16 v48, v56, v104, 0
    v_dot2_f32_bf16 v49, v57, v105, 0
    v_dot2_f32_bf16 v50, v58, v106, 0
    v_dot2_f32_bf16 v51, v59, v107, 0
    s_waitcnt vmcnt(15)
    v_cvt_f32_i32 v40, v168
    v_cvt_f32_i32 v41, v169
    v_cvt_f32_i32 v42, v170
    v_cvt_f32_i32 v43, v171
    buffer_load_dwordx4 v[168:171], v3, s[48:51], s56 offen offset:128 nt
    v_sub_f32 v40, v40, v85
    v_sub_f32 v41, v41, v85
    v_sub_f32 v42, v42, v85
    v_sub_f32 v43, v43, v85
    v_fmac_f32 v8, v40, v48
    v_fmac_f32 v9, v41, v49
    v_fmac_f32 v8, v42, v50
    v_fmac_f32 v9, v43, v51
    v_dot2_f32_bf16 v44, v60, v108, 0
    v_dot2_f32_bf16 v45, v61, v109, 0
    v_dot2_f32_bf16 v46, v62, v110, 0
    v_dot2_f32_bf16 v47, v63, v111, 0
    s_waitcnt vmcnt(15)
    v_cvt_f32_i32 v36, v172
    v_cvt_f32_i32 v37, v173
    v_cvt_f32_i32 v38, v174
    v_cvt_f32_i32 v39, v175
    buffer_load_dwordx4 v[172:175], v3, s[48:51], s56 offen offset:256 nt
    v_sub_f32 v36, v36, v85
    v_sub_f32 v37, v37, v85
    v_sub_f32 v38, v38, v85
    v_sub_f32 v39, v39, v85
    v_fmac_f32 v8, v36, v44
    v_fmac_f32 v9, v37, v45
    v_fmac_f32 v8, v38, v46
    v_fmac_f32 v9, v39, v47
    v_dot2_f32_bf16 v48, v64, v112, 0
    v_dot2_f32_bf16 v49, v65, v113, 0
    v_dot2_f32_bf16 v50, v66, v114, 0
    v_dot2_f32_bf16 v51, v67, v115, 0
    s_waitcnt vmcnt(15)
    v_cvt_f32_i32 v40, v176
    v_cvt_f32_i32 v41, v177
    v_cvt_f32_i32 v42, v178
    v_cvt_f32_i32 v43, v179
    buffer_load_dwordx4 v[176:179], v3, s[48:51], s56 offen offset:384 nt
    v_sub_f32 v40, v40, v85
    v_sub_f32 v41, v41, v85
    v_sub_f32 v42, v42, v85
    v_sub_f32 v43, v43, v85
    v_fmac_f32 v8, v40, v48
    v_fmac_f32 v9, v41, v49
    v_fmac_f32 v8, v42, v50
    v_fmac_f32 v9, v43, v51
    v_add_f32 v13, v8, v9
    v_dot2_f32_bf16 v44, v52, v116, 0
    v_dot2_f32_bf16 v45, v53, v117, 0
    v_dot2_f32_bf16 v46, v54, v118, 0
    v_dot2_f32_bf16 v47, v55, v119, 0
    s_waitcnt vmcnt(15)
    v_cvt_f32_i32 v36, v180
    v_cvt_f32_i32 v37, v181
    v_cvt_f32_i32 v38, v182
    v_cvt_f32_i32 v39, v183
    buffer_load_dwordx4 v[180:183], v3, s[48:51], s57 offen offset:0 nt
    v_sub_f32 v36, v36, v89
    v_sub_f32 v37, v37, v89
    v_sub_f32 v38, v38, v89
    v_sub_f32 v39, v39, v89
    v_mul_f32 v8, v36, v44
    v_mul_f32 v9, v37, v45
    v_fmac_f32 v8, v38, v46
    v_fmac_f32 v9, v39, v47
    v_dot2_f32_bf16 v48, v56, v120, 0
    v_dot2_f32_bf16 v49, v57, v121, 0
    v_dot2_f32_bf16 v50, v58, v122, 0
    v_dot2_f32_bf16 v51, v59, v123, 0
    s_waitcnt vmcnt(15)
    v_cvt_f32_i32 v40, v184
    v_cvt_f32_i32 v41, v185
    v_cvt_f32_i32 v42, v186
    v_cvt_f32_i32 v43, v187
    buffer_load_dwordx4 v[184:187], v3, s[48:51], s57 offen offset:128 nt
    v_sub_f32 v40, v40, v89
    v_sub_f32 v41, v41, v89
    v_sub_f32 v42, v42, v89
    v_sub_f32 v43, v43, v89
    v_fmac_f32 v8, v40, v48
    v_fmac_f32 v9, v41, v49
    v_fmac_f32 v8, v42, v50
    v_fmac_f32 v9, v43, v51
    v_dot2_f32_bf16 v44, v60, v124, 0
    v_dot2_f32_bf16 v45, v61, v125, 0
    v_dot2_f32_bf16 v46, v62, v126, 0
    v_dot2_f32_bf16 v47, v63, v127, 0
    s_waitcnt vmcnt(15)
    v_cvt_f32_i32 v36, v188
    v_cvt_f32_i32 v37, v189
    v_cvt_f32_i32 v38, v190
    v_cvt_f32_i32 v39, v191
    buffer_load_dwordx4 v[188:191], v3, s[48:51], s57 offen offset:256 nt
    v_sub_f32 v36, v36, v89
    v_sub_f32 v37, v37, v89
    v_sub_f32 v38, v38, v89
    v_sub_f32 v39, v39, v89
    v_fmac_f32 v8, v36, v44
    v_fmac_f32 v9, v37, v45
    v_fmac_f32 v8, v38, v46
    v_fmac_f32 v9, v39, v47
    v_dot2_f32_bf16 v48, v64, v128, 0
    v_dot2_f32_bf16 v49, v65, v129, 0
    v_dot2_f32_bf16 v50, v66, v130, 0
    v_dot2_f32_bf16 v51, v67, v131, 0
    s_waitcnt vmcnt(15)
    v_cvt_f32_i32 v40, v192
    v_cvt_f32_i32 v41, v193
    v_cvt_f32_i32 v42, v194
    v_cvt_f32_i32 v43, v195
    buffer_load_dwordx4 v[192:195], v3, s[48:51], s57 offen offset:384 nt
    v_sub_f32 v40, v40, v89
    v_sub_f32 v41, v41, v89
    v_sub_f32 v42, v42, v89
    v_sub_f32 v43, v43, v89
    v_fmac_f32 v8, v40, v48
    v_fmac_f32 v9, v41, v49
    v_fmac_f32 v8, v42, v50
    v_fmac_f32 v9, v43, v51
    v_add_f32 v14, v8, v9
    v_dot2_f32_bf16 v44, v52, v132, 0
    v_dot2_f32_bf16 v45, v53, v133, 0
    v_dot2_f32_bf16 v46, v54, v134, 0
    v_dot2_f32_bf16 v47, v55, v135, 0
    s_waitcnt vmcnt(15)
    v_cvt_f32_i32 v36, v196
    v_cvt_f32_i32 v37, v197
    v_cvt_f32_i32 v38, v198
    v_cvt_f32_i32 v39, v199
    buffer_load_dwordx4 v[196:199], v3, s[48:51], s58 offen offset:0 nt
    v_sub_f32 v36, v36, v93
    v_sub_f32 v37, v37, v93
    v_sub_f32 v38, v38, v93
    v_sub_f32 v39, v39, v93
    v_mul_f32 v8, v36, v44
    v_mul_f32 v9, v37, v45
    v_fmac_f32 v8, v38, v46
    v_fmac_f32 v9, v39, v47
    v_dot2_f32_bf16 v48, v56, v136, 0
    v_dot2_f32_bf16 v49, v57, v137, 0
    v_dot2_f32_bf16 v50, v58, v138, 0
    v_dot2_f32_bf16 v51, v59, v139, 0
    s_waitcnt vmcnt(15)
    v_cvt_f32_i32 v40, v200
    v_cvt_f32_i32 v41, v201
    v_cvt_f32_i32 v42, v202
    v_cvt_f32_i32 v43, v203
    buffer_load_dwordx4 v[200:203], v3, s[48:51], s58 offen offset:128 nt
    v_sub_f32 v40, v40, v93
    v_sub_f32 v41, v41, v93
    v_sub_f32 v42, v42, v93
    v_sub_f32 v43, v43, v93
    v_fmac_f32 v8, v40, v48
    v_fmac_f32 v9, v41, v49
    v_fmac_f32 v8, v42, v50
    v_fmac_f32 v9, v43, v51
    v_dot2_f32_bf16 v44, v60, v140, 0
    v_dot2_f32_bf16 v45, v61, v141, 0
    v_dot2_f32_bf16 v46, v62, v142, 0
    v_dot2_f32_bf16 v47, v63, v143, 0
    s_waitcnt vmcnt(15)
    v_cvt_f32_i32 v36, v204
    v_cvt_f32_i32 v37, v205
    v_cvt_f32_i32 v38, v206
    v_cvt_f32_i32 v39, v207
    buffer_load_dwordx4 v[204:207], v3, s[48:51], s58 offen offset:256 nt
    v_sub_f32 v36, v36, v93
    v_sub_f32 v37, v37, v93
    v_sub_f32 v38, v38, v93
    v_sub_f32 v39, v39, v93
    v_fmac_f32 v8, v36, v44
    v_fmac_f32 v9, v37, v45
    v_fmac_f32 v8, v38, v46
    v_fmac_f32 v9, v39, v47
    v_dot2_f32_bf16 v48, v64, v144, 0
    v_dot2_f32_bf16 v49, v65, v145, 0
    v_dot2_f32_bf16 v50, v66, v146, 0
    v_dot2_f32_bf16 v51, v67, v147, 0
    s_waitcnt vmcnt(15)
    v_cvt_f32_i32 v40, v208
    v_cvt_f32_i32 v41, v209
    v_cvt_f32_i32 v42, v210
    v_cvt_f32_i32 v43, v211
    buffer_load_dwordx4 v[208:211], v3, s[48:51], s58 offen offset:384 nt
    v_sub_f32 v40, v40, v93
    v_sub_f32 v41, v41, v93
    v_sub_f32 v42, v42, v93
    v_sub_f32 v43, v43, v93
    v_fmac_f32 v8, v40, v48
    v_fmac_f32 v9, v41, v49
    v_fmac_f32 v8, v42, v50
    v_fmac_f32 v9, v43, v51
    v_add_f32 v15, v8, v9
    v_dot2_f32_bf16 v44, v52, v148, 0
    v_dot2_f32_bf16 v45, v53, v149, 0
    v_dot2_f32_bf16 v46, v54, v150, 0
    v_dot2_f32_bf16 v47, v55, v151, 0
    s_waitcnt vmcnt(15)
    v_cvt_f32_i32 v36, v212
    v_cvt_f32_i32 v37, v213
    v_cvt_f32_i32 v38, v214
    v_cvt_f32_i32 v39, v215
    buffer_load_dwordx4 v[212:215], v3, s[48:51], s59 offen offset:0 nt
    v_sub_f32 v36, v36, v97
    v_sub_f32 v37, v37, v97
    v_sub_f32 v38, v38, v97
    v_sub_f32 v39, v39, v97
    v_mul_f32 v8, v36, v44
    v_mul_f32 v9, v37, v45
    v_fmac_f32 v8, v38, v46
    v_fmac_f32 v9, v39, v47
    v_dot2_f32_bf16 v48, v56, v152, 0
    v_dot2_f32_bf16 v49, v57, v153, 0
    v_dot2_f32_bf16 v50, v58, v154, 0
    v_dot2_f32_bf16 v51, v59, v155, 0
    s_waitcnt vmcnt(15)
    v_cvt_f32_i32 v40, v216
    v_cvt_f32_i32 v41, v217
    v_cvt_f32_i32 v42, v218
    v_cvt_f32_i32 v43, v219
    buffer_load_dwordx4 v[216:219], v3, s[48:51], s59 offen offset:128 nt
    v_sub_f32 v40, v40, v97
    v_sub_f32 v41, v41, v97
    v_sub_f32 v42, v42, v97
    v_sub_f32 v43, v43, v97
    v_fmac_f32 v8, v40, v48
    v_fmac_f32 v9, v41, v49
    v_fmac_f32 v8, v42, v50
    v_fmac_f32 v9, v43, v51
    v_dot2_f32_bf16 v44, v60, v156, 0
    v_dot2_f32_bf16 v45, v61, v157, 0
    v_dot2_f32_bf16 v46, v62, v158, 0
    v_dot2_f32_bf16 v47, v63, v159, 0
    s_waitcnt vmcnt(15)
    v_cvt_f32_i32 v36, v220
    v_cvt_f32_i32 v37, v221
    v_cvt_f32_i32 v38, v222
    v_cvt_f32_i32 v39, v223
    buffer_load_dwordx4 v[220:223], v3, s[48:51], s59 offen offset:256 nt
    v_sub_f32 v36, v36, v97
    v_sub_f32 v37, v37, v97
    v_sub_f32 v38, v38, v97
    v_sub_f32 v39, v39, v97
    v_fmac_f32 v8, v36, v44
    v_fmac_f32 v9, v37, v45
    v_fmac_f32 v8, v38, v46
    v_fmac_f32 v9, v39, v47
    v_dot2_f32_bf16 v48, v64, v160, 0
    v_dot2_f32_bf16 v49, v65, v161, 0
    v_dot2_f32_bf16 v50, v66, v162, 0
    v_dot2_f32_bf16 v51, v67, v163, 0
    s_waitcnt vmcnt(15)
    v_cvt_f32_i32 v40, v224
    v_cvt_f32_i32 v41, v225
    v_cvt_f32_i32 v42, v226
    v_cvt_f32_i32 v43, v227
    buffer_load_dwordx4 v[224:227], v3, s[48:51], s59 offen offset:384 nt
    v_add_u32 v3, 0x2000000, v3
    v_sub_f32 v40, v40, v97
    v_sub_f32 v41, v41, v97
    v_sub_f32 v42, v42, v97
    v_sub_f32 v43, v43, v97
    v_fmac_f32 v8, v40, v48
    v_fmac_f32 v9, v41, v49
    v_fmac_f32 v8, v42, v50
    v_fmac_f32 v9, v43, v51
    v_add_f32 v16, v8, v9
    s_nop 1
    v_add_f32_dpp v13, v13, v13 quad_perm:[1,0,3,2] row_mask:0xf bank_mask:0xf
    v_add_f32_dpp v14, v14, v14 quad_perm:[1,0,3,2] row_mask:0xf bank_mask:0xf
    v_add_f32_dpp v15, v15, v15 quad_perm:[1,0,3,2] row_mask:0xf bank_mask:0xf
    v_add_f32_dpp v16, v16, v16 quad_perm:[1,0,3,2] row_mask:0xf bank_mask:0xf
    v_add_f32_dpp v13, v13, v13 quad_perm:[2,3,0,1] row_mask:0xf bank_mask:0xf
    v_add_f32_dpp v14, v14, v14 quad_perm:[2,3,0,1] row_mask:0xf bank_mask:0xf
    v_add_f32_dpp v15, v15, v15 quad_perm:[2,3,0,1] row_mask:0xf bank_mask:0xf
    v_add_f32_dpp v16, v16, v16 quad_perm:[2,3,0,1] row_mask:0xf bank_mask:0xf
    v_add_f32_dpp v13, v13, v13 row_half_mirror row_mask:0xf bank_mask:0xf
    v_add_f32_dpp v14, v14, v14 row_half_mirror row_mask:0xf bank_mask:0xf
    v_add_f32_dpp v15, v15, v15 row_half_mirror row_mask:0xf bank_mask:0xf
    v_add_f32_dpp v16, v16, v16 row_half_mirror row_mask:0xf bank_mask:0xf
    v_mul_f32 v13, v13, v84
    v_mul_f32 v14, v14, v88
    v_mul_f32 v15, v15, v92
    v_mul_f32 v16, v16, v96
    v_max_f32 v10, v13, v14
    v_max3_f32 v10, v10, v15, v16
    s_nop 1
    v_max_f32_dpp v36, v10, v10 row_ror:8 row_mask:0xf bank_mask:0xf
    v_mov_b32 v37, v36
    s_nop 1
    v_permlane16_swap_b32 v36, v37
    v_max_f32 v36, v36, v37
    v_mov_b32 v37, v36
    s_nop 1
    v_permlane32_swap_b32 v36, v37
    v_max_f32 v10, v36, v37
    v_sub_f32 v13, v13, v10
    v_sub_f32 v14, v14, v10
    v_sub_f32 v15, v15, v10
    v_sub_f32 v16, v16, v10
    v_exp_f32 v13, v13
    v_exp_f32 v14, v14
    v_exp_f32 v15, v15
    v_exp_f32 v16, v16
    s_nop 0
    v_mul_f32 v17, v13, v86
    v_mul_f32 v18, v14, v90
    v_mul_f32 v19, v15, v94
    v_mul_f32 v20, v16, v98
    v_add_f32 v11, v13, v14
    v_mul_f32 v12, v17, v87
    v_add_f32 v11, v11, v15
    v_add_f32 v11, v11, v16
    v_fmac_f32 v12, v18, v91
    v_fmac_f32 v12, v19, v95
    v_fmac_f32 v12, v20, v99
    v_add_u32 v5, 512, v5
    ds_read_b128 v[84:87], v5 offset:2560
    ds_read_b128 v[88:91], v5 offset:2688
    ds_read_b128 v[92:95], v5 offset:2816
    ds_read_b128 v[96:99], v5 offset:2944
    s_waitcnt vmcnt(15)
    v_cvt_f32_i32 v36, v164
    v_cvt_f32_i32 v37, v165
    v_cvt_f32_i32 v38, v166
    v_cvt_f32_i32 v39, v167
    buffer_load_dwordx4 v[164:167], v2, s[44:47], s56 offen offset:0 nt
    v_fma_f32 v68, v17, v36, -v12
    v_fma_f32 v69, v17, v37, -v12
    v_fma_f32 v70, v17, v38, -v12
    v_fma_f32 v71, v17, v39, -v12
    s_waitcnt vmcnt(15)
    v_cvt_f32_i32 v40, v168
    v_cvt_f32_i32 v41, v169
    v_cvt_f32_i32 v42, v170
    v_cvt_f32_i32 v43, v171
    buffer_load_dwordx4 v[168:171], v2, s[44:47], s56 offen offset:128 nt
    v_fma_f32 v72, v17, v40, -v12
    v_fma_f32 v73, v17, v41, -v12
    v_fma_f32 v74, v17, v42, -v12
    v_fma_f32 v75, v17, v43, -v12
    s_waitcnt vmcnt(15)
    v_cvt_f32_i32 v36, v172
    v_cvt_f32_i32 v37, v173
    v_cvt_f32_i32 v38, v174
    v_cvt_f32_i32 v39, v175
    buffer_load_dwordx4 v[172:175], v2, s[44:47], s56 offen offset:256 nt
    v_fma_f32 v76, v17, v36, -v12
    v_fma_f32 v77, v17, v37, -v12
    v_fma_f32 v78, v17, v38, -v12
    v_fma_f32 v79, v17, v39, -v12
    s_waitcnt vmcnt(15)
    v_cvt_f32_i32 v40, v176
    v_cvt_f32_i32 v41, v177
    v_cvt_f32_i32 v42, v178
    v_cvt_f32_i32 v43, v179
    buffer_load_dwordx4 v[176:179], v2, s[44:47], s56 offen offset:384 nt
    v_fma_f32 v80, v17, v40, -v12
    v_fma_f32 v81, v17, v41, -v12
    v_fma_f32 v82, v17, v42, -v12
    v_fma_f32 v83, v17, v43, -v12
    s_waitcnt vmcnt(15)
    v_cvt_f32_i32 v36, v180
    v_cvt_f32_i32 v37, v181
    v_cvt_f32_i32 v38, v182
    v_cvt_f32_i32 v39, v183
    buffer_load_dwordx4 v[180:183], v2, s[44:47], s57 offen offset:0 nt
    v_fmac_f32 v68, v18, v36
    v_fmac_f32 v69, v18, v37
    v_fmac_f32 v70, v18, v38
    v_fmac_f32 v71, v18, v39
    s_waitcnt vmcnt(15)
    v_cvt_f32_i32 v40, v184
    v_cvt_f32_i32 v41, v185
    v_cvt_f32_i32 v42, v186
    v_cvt_f32_i32 v43, v187
    buffer_load_dwordx4 v[184:187], v2, s[44:47], s57 offen offset:128 nt
    v_fmac_f32 v72, v18, v40
    v_fmac_f32 v73, v18, v41
    v_fmac_f32 v74, v18, v42
    v_fmac_f32 v75, v18, v43
    s_waitcnt vmcnt(15)
    v_cvt_f32_i32 v36, v188
    v_cvt_f32_i32 v37, v189
    v_cvt_f32_i32 v38, v190
    v_cvt_f32_i32 v39, v191
    buffer_load_dwordx4 v[188:191], v2, s[44:47], s57 offen offset:256 nt
    v_fmac_f32 v76, v18, v36
    v_fmac_f32 v77, v18, v37
    v_fmac_f32 v78, v18, v38
    v_fmac_f32 v79, v18, v39
    s_waitcnt vmcnt(15)
    v_cvt_f32_i32 v40, v192
    v_cvt_f32_i32 v41, v193
    v_cvt_f32_i32 v42, v194
    v_cvt_f32_i32 v43, v195
    buffer_load_dwordx4 v[192:195], v2, s[44:47], s57 offen offset:384 nt
    v_fmac_f32 v80, v18, v40
    v_fmac_f32 v81, v18, v41
    v_fmac_f32 v82, v18, v42
    v_fmac_f32 v83, v18, v43
    s_waitcnt vmcnt(15)
    v_cvt_f32_i32 v36, v196
    v_cvt_f32_i32 v37, v197
    v_cvt_f32_i32 v38, v198
    v_cvt_f32_i32 v39, v199
    buffer_load_dwordx4 v[196:199], v2, s[44:47], s58 offen offset:0 nt
    v_fmac_f32 v68, v19, v36
    v_fmac_f32 v69, v19, v37
    v_fmac_f32 v70, v19, v38
    v_fmac_f32 v71, v19, v39
    s_waitcnt vmcnt(15)
    v_cvt_f32_i32 v40, v200
    v_cvt_f32_i32 v41, v201
    v_cvt_f32_i32 v42, v202
    v_cvt_f32_i32 v43, v203
    buffer_load_dwordx4 v[200:203], v2, s[44:47], s58 offen offset:128 nt
    v_fmac_f32 v72, v19, v40
    v_fmac_f32 v73, v19, v41
    v_fmac_f32 v74, v19, v42
    v_fmac_f32 v75, v19, v43
    s_waitcnt vmcnt(15)
    v_cvt_f32_i32 v36, v204
    v_cvt_f32_i32 v37, v205
    v_cvt_f32_i32 v38, v206
    v_cvt_f32_i32 v39, v207
    buffer_load_dwordx4 v[204:207], v2, s[44:47], s58 offen offset:256 nt
    v_fmac_f32 v76, v19, v36
    v_fmac_f32 v77, v19, v37
    v_fmac_f32 v78, v19, v38
    v_fmac_f32 v79, v19, v39
    s_waitcnt vmcnt(15)
    v_cvt_f32_i32 v40, v208
    v_cvt_f32_i32 v41, v209
    v_cvt_f32_i32 v42, v210
    v_cvt_f32_i32 v43, v211
    buffer_load_dwordx4 v[208:211], v2, s[44:47], s58 offen offset:384 nt
    v_fmac_f32 v80, v19, v40
    v_fmac_f32 v81, v19, v41
    v_fmac_f32 v82, v19, v42
    v_fmac_f32 v83, v19, v43
    s_waitcnt vmcnt(15)
    v_cvt_f32_i32 v36, v212
    v_cvt_f32_i32 v37, v213
    v_cvt_f32_i32 v38, v214
    v_cvt_f32_i32 v39, v215
    buffer_load_dwordx4 v[212:215], v2, s[44:47], s59 offen offset:0 nt
    v_fmac_f32 v68, v20, v36
    v_fmac_f32 v69, v20, v37
    v_fmac_f32 v70, v20, v38
    v_fmac_f32 v71, v20, v39
    s_waitcnt vmcnt(15)
    v_cvt_f32_i32 v40, v216
    v_cvt_f32_i32 v41, v217
    v_cvt_f32_i32 v42, v218
    v_cvt_f32_i32 v43, v219
    buffer_load_dwordx4 v[216:219], v2, s[44:47], s59 offen offset:128 nt
    v_fmac_f32 v72, v20, v40
    v_fmac_f32 v73, v20, v41
    v_fmac_f32 v74, v20, v42
    v_fmac_f32 v75, v20, v43
    s_waitcnt vmcnt(15)
    v_cvt_f32_i32 v36, v220
    v_cvt_f32_i32 v37, v221
    v_cvt_f32_i32 v38, v222
    v_cvt_f32_i32 v39, v223
    buffer_load_dwordx4 v[220:223], v2, s[44:47], s59 offen offset:256 nt
    v_fmac_f32 v76, v20, v36
    v_fmac_f32 v77, v20, v37
    v_fmac_f32 v78, v20, v38
    v_fmac_f32 v79, v20, v39
    s_waitcnt vmcnt(15)
    v_cvt_f32_i32 v40, v224
    v_cvt_f32_i32 v41, v225
    v_cvt_f32_i32 v42, v226
    v_cvt_f32_i32 v43, v227
    buffer_load_dwordx4 v[224:227], v2, s[44:47], s59 offen offset:384 nt
    v_add_u32 v2, 0x2000000, v2
    v_fmac_f32 v80, v20, v40
    v_fmac_f32 v81, v20, v41
    v_fmac_f32 v82, v20, v42
    v_fmac_f32 v83, v20, v43
    v_add_f32_dpp v36, v11, v11 row_ror:8 row_mask:0xf bank_mask:0xf
    v_mov_b32 v37, v36
    v_permlane32_swap_b32 v68, v76
    v_permlane32_swap_b32 v69, v77
    v_permlane32_swap_b32 v70, v78
    v_permlane32_swap_b32 v71, v79
    v_permlane32_swap_b32 v72, v80
    v_permlane32_swap_b32 v73, v81
    v_permlane32_swap_b32 v74, v82
    v_permlane32_swap_b32 v75, v83
    v_permlane16_swap_b32 v36, v37
    v_add_f32 v68, v68, v76
    v_add_f32 v69, v69, v77
    v_add_f32 v70, v70, v78
    v_add_f32 v71, v71, v79
    v_add_f32 v72, v72, v80
    v_add_f32 v73, v73, v81
    v_add_f32 v74, v74, v82
    v_add_f32 v75, v75, v83
    v_add_f32 v36, v36, v37
    v_mov_b32 v37, v36
    v_permlane16_swap_b32 v68, v72
    v_permlane16_swap_b32 v69, v73
    v_permlane16_swap_b32 v70, v74
    v_permlane16_swap_b32 v71, v75
    v_permlane32_swap_b32 v36, v37
    v_add_f32 v68, v68, v72
    v_add_f32 v69, v69, v73
    v_add_f32 v70, v70, v74
    v_add_f32 v71, v71, v75
    v_add_f32 v11, v36, v37
    s_mul_i32 s4, s55, 64
    v_add_f32_dpp v72, v68, v68 row_ror:8 row_mask:0xf bank_mask:0xf
    v_add_f32_dpp v73, v69, v69 row_ror:8 row_mask:0xf bank_mask:0xf
    v_add_f32_dpp v74, v70, v70 row_ror:8 row_mask:0xf bank_mask:0xf
    v_add_f32_dpp v75, v71, v71 row_ror:8 row_mask:0xf bank_mask:0xf
    s_lshl_b32 s5, s54, 3
    s_add_u32 s4, s4, s5
    s_add_u32 s4, s4, 16384
    v_mov_b32 v36, s4
    ds_write_b128 v6, v[72:75]
    s_mov_b64 exec, 1
    ds_write_b64 v36, v[10:11]
    s_mov_b64 exec, -1
    v_add_u32 v6, 4096, v6
    s_add_u32 s55, s55, 1
    s_cmp_lt_u32 s55, 4
    s_cbranch_scc1 L_loop
    s_waitcnt lgkmcnt(0)
    s_barrier
    s_cmp_ge_u32 s54, 4
    s_cbranch_scc1 L_end
    s_lshl_b32 s3, s66, 4
    s_add_u32 s40, s40, s3
    s_addc_u32 s41, s41, 0
    v_mov_b32 v8, 0
    v_mov_b32 v9, 1
    v_mov_b32 v12, 17152
    s_mul_i32 s4, s54, 4096
    v_lshlrev_b32 v68, 3, v1
    v_add_u32 v69, s4, v68
    s_mul_i32 s4, s54, 64
    s_add_u32 s4, s4, 16384
    v_mov_b32 v70, s4
    ds_read_b128 v[52:55], v70 offset:0
    ds_read_b128 v[56:59], v70 offset:16
    ds_read_b128 v[60:63], v70 offset:32
    ds_read_b128 v[64:67], v70 offset:48
    ds_read_b64 v[36:37], v69 offset:0
    ds_read_b64 v[38:39], v69 offset:512
    ds_read_b64 v[40:41], v69 offset:1024
    ds_read_b64 v[42:43], v69 offset:1536
    ds_read_b64 v[44:45], v69 offset:2048
    ds_read_b64 v[46:47], v69 offset:2560
    ds_read_b64 v[48:49], v69 offset:3072
    ds_read_b64 v[50:51], v69 offset:3584
    s_waitcnt lgkmcnt(8)
    v_max_f32 v72, v52, v54
    v_max3_f32 v72, v72, v56, v58
    v_max3_f32 v72, v72, v60, v62
    v_max3_f32 v72, v72, v64, v66
    v_sub_f32 v52, v52, v72
    v_sub_f32 v54, v54, v72
    v_sub_f32 v56, v56, v72
    v_sub_f32 v58, v58, v72
    v_sub_f32 v60, v60, v72
    v_sub_f32 v62, v62, v72
    v_sub_f32 v64, v64, v72
    v_sub_f32 v66, v66, v72
    v_exp_f32 v52, v52
    v_exp_f32 v54, v54
    v_exp_f32 v56, v56
    v_exp_f32 v58, v58
    v_exp_f32 v60, v60
    v_exp_f32 v62, v62
    v_exp_f32 v64, v64
    v_exp_f32 v66, v66
    s_waitcnt lgkmcnt(0)
    v_mul_f32 v73, v52, v53
    v_mul_f32 v74, v52, v36
    v_mul_f32 v75, v52, v37
    v_fmac_f32 v73, v54, v55
    v_fmac_f32 v74, v54, v38
    v_fmac_f32 v75, v54, v39
    v_fmac_f32 v73, v56, v57
    v_fmac_f32 v74, v56, v40
    v_fmac_f32 v75, v56, v41
    v_fmac_f32 v73, v58, v59
    v_fmac_f32 v74, v58, v42
    v_fmac_f32 v75, v58, v43
    v_fmac_f32 v73, v60, v61
    v_fmac_f32 v74, v60, v44
    v_fmac_f32 v75, v60, v45
    v_fmac_f32 v73, v62, v63
    v_fmac_f32 v74, v62, v46
    v_fmac_f32 v75, v62, v47
    v_fmac_f32 v73, v64, v65
    v_fmac_f32 v74, v64, v48
    v_fmac_f32 v75, v64, v49
    v_fmac_f32 v73, v66, v67
    v_fmac_f32 v74, v66, v50
    v_fmac_f32 v75, v66, v51
    v_mov_b32 v71, 0
    global_store_dwordx2 v68, v[74:75], s[10:11] sc1
    s_mov_b64 exec, 1
    global_store_dwordx2 v71, v[72:73], s[14:15] sc1
    s_mov_b64 exec, -1
    s_waitcnt vmcnt(0)
    s_barrier
    s_cmp_lg_u32 s54, 0
    s_cbranch_scc1 L_noat
    s_mov_b64 exec, 1
    global_atomic_add v9, v8, v9, s[40:41] sc0
    s_mov_b64 exec, -1
L_noat:
    s_cmp_lg_u32 s54, 0
    s_cbranch_scc1 L_vb1
    s_waitcnt vmcnt(0)
    s_mov_b64 exec, 1
    ds_write_b32 v12, v9
    s_mov_b64 exec, -1
    s_waitcnt lgkmcnt(0)
L_vb1:
    s_barrier
    ds_read_b32 v70, v12
    s_waitcnt lgkmcnt(0)
    v_readfirstlane_b32 s3, v70
    s_cmp_lg_u32 s3, 15
    s_cbranch_scc1 L_end
    s_lshl_b32 s3, s72, 8
    s_add_u32 s38, s38, s3
    s_addc_u32 s39, s39, 0
    v_lshlrev_b32 v8, 3, v1
    v_add_u32 v9, 4096, v8
    v_and_b32 v12, 15, v1
    v_lshlrev_b32 v12, 3, v12
    global_load_dwordx2 v[10:11], v12, s[12:13] sc1
    global_load_dwordx2 v[18:19], v8, s[8:9] offset:0 sc1
    global_load_dwordx2 v[20:21], v8, s[8:9] offset:512 sc1
    global_load_dwordx2 v[22:23], v8, s[8:9] offset:1024 sc1
    global_load_dwordx2 v[24:25], v8, s[8:9] offset:1536 sc1
    global_load_dwordx2 v[26:27], v8, s[8:9] offset:2048 sc1
    global_load_dwordx2 v[28:29], v8, s[8:9] offset:2560 sc1
    global_load_dwordx2 v[30:31], v8, s[8:9] offset:3072 sc1
    global_load_dwordx2 v[32:33], v8, s[8:9] offset:3584 sc1
    global_load_dwordx2 v[34:35], v9, s[8:9] offset:0 sc1
    global_load_dwordx2 v[36:37], v9, s[8:9] offset:512 sc1
    global_load_dwordx2 v[38:39], v9, s[8:9] offset:1024 sc1
    global_load_dwordx2 v[40:41], v9, s[8:9] offset:1536 sc1
    global_load_dwordx2 v[42:43], v9, s[8:9] offset:2048 sc1
    global_load_dwordx2 v[44:45], v9, s[8:9] offset:2560 sc1
    global_load_dwordx2 v[46:47], v9, s[8:9] offset:3072 sc1
    global_load_dwordx2 v[48:49], v9, s[8:9] offset:3584 sc1
    s_waitcnt vmcnt(16)
    s_nop 1
    v_max_f32_dpp v14, v10, v10 quad_perm:[1,0,3,2] row_mask:0xf bank_mask:0xf
    s_nop 1
    v_max_f32_dpp v14, v14, v14 quad_perm:[2,3,0,1] row_mask:0xf bank_mask:0xf
    s_nop 1
    v_max_f32_dpp v14, v14, v14 row_half_mirror row_mask:0xf bank_mask:0xf
    s_nop 1
    v_max_f32_dpp v14, v14, v14 row_mirror row_mask:0xf bank_mask:0xf
    v_sub_f32 v15, v10, v14
    v_exp_f32 v15, v15
    s_nop 0
    v_mul_f32 v12, v15, v11
    s_nop 1
    v_add_f32_dpp v12, v12, v12 quad_perm:[1,0,3,2] row_mask:0xf bank_mask:0xf
    s_nop 1
    v_add_f32_dpp v12, v12, v12 quad_perm:[2,3,0,1] row_mask:0xf bank_mask:0xf
    s_nop 1
    v_add_f32_dpp v12, v12, v12 row_half_mirror row_mask:0xf bank_mask:0xf
    s_nop 1
    v_add_f32_dpp v12, v12, v12 row_mirror row_mask:0xf bank_mask:0xf
    v_rcp_f32 v12, v12
    v_mov_b32 v14, 0
    v_mov_b32 v10, 0
    v_readlane_b32 s74, v15, 0
    v_readlane_b32 s75, v15, 1
    v_readlane_b32 s76, v15, 2
    v_readlane_b32 s77, v15, 3
    v_readlane_b32 s78, v15, 4
    v_readlane_b32 s79, v15, 5
    v_readlane_b32 s80, v15, 6
    v_readlane_b32 s81, v15, 7
    v_readlane_b32 s82, v15, 8
    v_readlane_b32 s83, v15, 9
    v_readlane_b32 s84, v15, 10
    v_readlane_b32 s85, v15, 11
    v_readlane_b32 s86, v15, 12
    v_readlane_b32 s87, v15, 13
    v_readlane_b32 s88, v15, 14
    v_readlane_b32 s89, v15, 15
    s_waitcnt vmcnt(0)
    s_nop 0
    v_fmac_f32 v14, s74, v18
    v_fmac_f32 v10, s74, v19
    v_fmac_f32 v14, s75, v20
    v_fmac_f32 v10, s75, v21
    v_fmac_f32 v14, s76, v22
    v_fmac_f32 v10, s76, v23
    v_fmac_f32 v14, s77, v24
    v_fmac_f32 v10, s77, v25
    v_fmac_f32 v14, s78, v26
    v_fmac_f32 v10, s78, v27
    v_fmac_f32 v14, s79, v28
    v_fmac_f32 v10, s79, v29
    v_fmac_f32 v14, s80, v30
    v_fmac_f32 v10, s80, v31
    v_fmac_f32 v14, s81, v32
    v_fmac_f32 v10, s81, v33
    v_fmac_f32 v14, s82, v34
    v_fmac_f32 v10, s82, v35
    v_fmac_f32 v14, s83, v36
    v_fmac_f32 v10, s83, v37
    v_fmac_f32 v14, s84, v38
    v_fmac_f32 v10, s84, v39
    v_fmac_f32 v14, s85, v40
    v_fmac_f32 v10, s85, v41
    v_fmac_f32 v14, s86, v42
    v_fmac_f32 v10, s86, v43
    v_fmac_f32 v14, s87, v44
    v_fmac_f32 v10, s87, v45
    v_fmac_f32 v14, s88, v46
    v_fmac_f32 v10, s88, v47
    v_fmac_f32 v14, s89, v48
    v_fmac_f32 v10, s89, v49
    v_mul_f32 v14, v14, v12
    v_mul_f32 v10, v10, v12
    v_cvt_pk_bf16_f32 v14, v14, v10
    v_lshlrev_b32 v10, 2, v1
    global_store_dword v10, v14, s[38:39]
L_end:
    s_endpgm
.section .rodata,"a"
.p2align 6
.amdhsa_kernel standalone__kv_cache_quant_pre_rope_vs_post_rope__decode_kernel
  .amdhsa_next_free_vgpr 240
  .amdhsa_next_free_sgpr 102
  .amdhsa_accum_offset 240
  .amdhsa_group_segment_fixed_size 0
  .amdhsa_kernarg_size 112
  .amdhsa_user_sgpr_count 2
  .amdhsa_user_sgpr_kernarg_segment_ptr 1
  .amdhsa_system_sgpr_workgroup_id_x 1
  .amdhsa_float_denorm_mode_32 3
.end_amdhsa_kernel
```
